```python
import torch

def _softmax(x, axis=-1):
    return torch.softmax(x, dim=axis)
def _gelu(x):
    return torch.nn.functional.gelu(x, approximate="tanh")
def _silu(x):
    return torch.nn.functional.silu(x)
def _sigmoid(x):
    return torch.sigmoid(x)
def _layernorm(x, axis=-1, eps=1e-5):
    m = x.mean(dim=axis, keepdim=True)
    v = x.var(dim=axis, keepdim=True, unbiased=False)
    return (x - m) / torch.sqrt(v + eps)
def _scatter_add(tgt, idx, src, axis=0):
    return tgt.clone().index_add_(axis, idx, src)
def _segment_sum(src, seg, n):
    out = torch.zeros((n,) + src.shape[1:], dtype=src.dtype)
    return out.index_add_(0, seg, src)
def _pad(x, pw):
    flat = tuple(v for pair in reversed(pw) for v in pair)
    return torch.nn.functional.pad(x, flat)

kernel_name = 'parallel_sum__sliding_block_cached__geglu_ffn__decode'

def setup_inputs():

    _w = (lambda a: (lambda t: t.to(torch.bfloat16) if t.is_floating_point() else t)(torch.as_tensor(a)))
    def _A_setup():
        B, Sq, D = 1, 1, 576
        Hq, Hkv, Sk, Dh = 32, 16, 65536, 128
        assert Hq % Hkv == 0, (Hq, Hkv)
        return {
            "x": _w((lambda *s: torch.randn(*s, dtype=torch.bfloat16) * 0.05)(B, Sq, D)),
            "k_cache": _w((lambda *s: torch.randn(*s, dtype=torch.bfloat16) * 3.2)(B, Hkv, Sk, Dh)),
            "v_cache": _w((lambda *s: torch.randn(*s, dtype=torch.bfloat16) * 1.6)(B, Hkv, Sk, Dh)),
            "wq": _w((lambda *s: torch.randn(*s, dtype=torch.bfloat16) * 3.2)(D, Hq * Dh) * (D ** -0.5)),
            "wo": _w((lambda *s: torch.randn(*s, dtype=torch.bfloat16) * 1.6)(Hq * Dh, D) * ((Hq * Dh) ** -0.5)),
        }
    _A_in = _A_setup()

    def _B_setup():
        B, S, D, F = 1, 1, 576, 4608
        return {
            "x": _w((lambda *s: torch.randn(*s, dtype=torch.bfloat16) * 0.05)(B, S, D)),
            "w_gate": _w((lambda *s: torch.randn(*s, dtype=torch.bfloat16) * 0.05)(D, F)),
            "w_up": _w((lambda *s: torch.randn(*s, dtype=torch.bfloat16) * 0.05)(D, F)),
            "w_down": _w((lambda *s: torch.randn(*s, dtype=torch.bfloat16) * 0.05)(F, D)),
        }
    _B_in = _B_setup()

    return {
        "A_x": _A_in["x"],
        "A_k_cache": _A_in["k_cache"],
        "A_v_cache": _A_in["v_cache"],
        "A_wq": _A_in["wq"],
        "A_wo": _A_in["wo"],
        "B_x": _B_in["x"],
        "B_w_gate": _B_in["w_gate"],
        "B_w_up": _B_in["w_up"],
        "B_w_down": _B_in["w_down"],
    }

def reference(A_x, A_k_cache, A_v_cache, A_wq, A_wo, B_x, B_w_gate, B_w_up, B_w_down):
    def _A_ref(x, k_cache, v_cache, wq, wo):
        B, Sq, D = x.shape
        Hq, Dh = 32, 128
        Hkv, Sk = k_cache.shape[1], k_cache.shape[2]
        W = min(4096, max(256, Sk // 4))
        rep = Hq // Hkv
        q = (lambda x, *d: x.permute(*d))((x @ wq).reshape(B, Sq, Hq, Dh), 0, 2, 1, 3)
        k = (lambda x, n, axis: torch.repeat_interleave(x, n, dim=axis))(k_cache[:, :, Sk - W:, :], rep, axis=1)
        v = (lambda x, n, axis: torch.repeat_interleave(x, n, dim=axis))(v_cache[:, :, Sk - W:, :], rep, axis=1)
        scores = torch.einsum("bhqd,bhkd->bhqk", q, k) * (Dh ** -0.5)
        p = _softmax(scores, axis=-1)
        o = torch.einsum("bhqk,bhkd->bhqd", p, v)
        return (lambda x, *d: x.permute(*d))(o, 0, 2, 1, 3).reshape(B, Sq, Hq * Dh) @ wo

    def _B_ref(x, w_gate, w_up, w_down):
        return (_gelu(x @ w_gate) * (x @ w_up)) @ w_down

    x = A_x
    xn = _layernorm(x, axis=-1)
    return x + _A_ref(xn, A_k_cache, A_v_cache, A_wq, A_wo) + _B_ref(xn, B_w_gate, B_w_up, B_w_down)
```

```asm
; @launch grid=(256,1,1) block=(768,1,1) lds=14848
.amdgcn_target "amdgcn-amd-amdhsa--gfx950"
.text
.globl parallel_sum__sliding_block_cached__geglu_ffn__decode_kernel
.p2align 12
.fill 448, 4, 0xbf810000
.p2align 8
.type parallel_sum__sliding_block_cached__geglu_ffn__decode_kernel,@function
parallel_sum__sliding_block_cached__geglu_ffn__decode_kernel:
  s_load_dwordx2 s[12:13], s[0:1], 8
  s_load_dwordx2 s[4:5], s[0:1], 0
  s_load_dwordx2 s[8:9], s[0:1], 24
  s_load_dwordx2 s[28:29], s[0:1], 88
  v_readfirstlane_b32 s3, v0
  s_cmp_ge_u32 s2, 256
  s_cbranch_scc1 L_end
  s_getpc_b64 s[56:57]
L_pc:
  v_lshlrev_b32 v1, 4, v0
  v_min_u32 v1, L_end-L_pc, v1
  global_load_dword v47, v1, s[56:57]
  s_and_b32 s36, s2, 15
  s_lshr_b32 s37, s2, 4
  s_lshl_b32 s87, s36, 1
  s_lshr_b32 s54, s36, 3
  s_or_b32 s87, s87, s54
  s_and_b32 s87, s87, 15
  s_sub_u32 s3, s3, 256
  s_cbranch_scc1 L_xhead
  v_and_b32 v0, 63, v0
  v_lshlrev_b32 v1, 4, v0
  s_lshl_b32 s92, s87, 8
  s_add_u32 s92, s92, s37
  s_addk_i32 s92, 240
  s_lshl_b32 s92, s92, 16
  s_add_u32 s43, s37, s36
  s_lshl_b32 s43, s43, 7
  s_add_u32 s43, s43, s3
  s_lshl_b32 s43, s43, 5
  s_and_b32 s43, s43, 0xffff
  s_or_b32 s43, s43, s92
  s_brev_b32 s14, 8
  s_mov_b32 s15, 0x20000
  s_mov_b32 s44, s43
  s_waitcnt lgkmcnt(0)
  buffer_load_dwordx4 v[56:59], v1, s[12:15], s43 offen offset:0 nt
  s_branch L_kv
L_xhead:
  s_setprio 2
  v_and_b32 v0, 63, v0
  s_bfe_u32 s3, s3, 0x20006
  v_lshlrev_b32 v1, 4, v0
  s_mov_b32 s6, 1152
  s_mov_b32 s7, 0x20000
  s_mov_b32 s10, 4718592
  s_mov_b32 s11, 0x20000
  v_mov_b32 v24, 0
  v_mov_b32 v25, 0
  v_mov_b32 v26, 0
  v_mov_b32 v27, 0
  ds_write_b128 v24, v[24:27] offset:0
  v_lshrrev_b32 v33, 5, v0
  v_bfe_u32 v34, v0, 3, 1
  v_bfe_u32 v35, v0, 4, 1
  v_lshl_add_u32 v36, v34, 1, v35
  v_add_u32 v36, 14, v36
  v_lshl_add_u32 v33, v33, 1, v34
  v_lshl_add_u32 v33, v33, 2, v35
  v_and_b32 v34, 7, v0
  v_lshlrev_b32 v34, 4, v34
  v_and_b32 v35, 32, v0
  v_lshl_add_u32 v3, v33, 13, v34
  v_lshl_add_u32 v4, v36, 13, v34
  v_lshl_add_u32 v4, v35, 25, v4
  v_lshlrev_b32 v35, 2, v0
  v_and_b32 v36, 0x38, v0
  v_lshrrev_b32 v37, 1, v36
  s_lshr_b32 s43, s3, 1
  s_andn2_b32 s54, s37, 1
  s_add_u32 s54, s54, s43
  s_mul_i32 s57, s54, 72
  s_lshl_b32 s40, s57, 12
  s_lshl_b32 s54, s87, 2
  s_and_b32 s44, s37, 1
  s_lshl_b32 s55, s44, 1
  s_add_u32 s54, s54, s55
  s_and_b32 s55, s3, 1
  s_add_u32 s54, s54, s55
  s_lshl_b32 s54, s54, 7
  s_add_u32 s40, s40, s54
  s_waitcnt lgkmcnt(0)
  buffer_load_dwordx4 v[88:91], v1, s[4:7], 0 offen
  buffer_load_dword v92, v35, s[4:7], 0 offen offset:1024
  buffer_load_dwordx2 v[104:105], v36, s[4:7], s57 offen
  buffer_load_dword v106, v37, s[4:7], s57 offen offset:64
  buffer_load_dwordx4 v[56:59], v3, s[8:11], s40 offen nt
  s_add_u32 s40, s40, 131072
  buffer_load_dwordx4 v[60:63], v3, s[8:11], s40 offen nt
  s_sub_u32 s40, s40, 114688
  buffer_load_dwordx4 v[64:67], v3, s[8:11], s40 offen nt
  s_add_u32 s40, s40, 131072
  buffer_load_dwordx4 v[68:71], v3, s[8:11], s40 offen nt
  buffer_load_dwordx4 v[72:75], v4, s[8:11], s40 offen nt
  s_barrier
  s_branch L_x
L_kv:
  s_barrier
  buffer_load_dwordx4 v[60:63], v1, s[12:15], s43 offen offset:1024 nt
  s_add_u32 s43, s43, 16384
  s_and_b32 s43, s43, 65535
  s_or_b32 s43, s43, s92
  s_lshr_b32 s39, s2, 7
  s_and_b32 s54, s2, 8
  s_add_u32 s54, s54, 48
  s_lshl_b32 s55, s39, 5
  s_sub_u32 s55, 64, s55
  s_load_dwordx2 s[20:21], s[0:1], s54
  s_load_dwordx2 s[24:25], s[0:1], s55
  s_load_dwordx2 s[16:17], s[0:1], 16
  s_lshr_b32 s3, s3, 6
  v_mov_b32 v24, 0
  s_brev_b32 s18, 8
  s_mov_b32 s19, 0x20000
  v_and_b32 v28, 0xf0, v1
  v_bfe_u32 v33, v0, 4, 1
  v_lshl_add_u32 v28, v33, 10, v28
  v_lshrrev_b32 v33, 5, v0
  v_lshl_add_u32 v28, v33, 8, v28
  s_and_b32 s38, s2, 7
  s_mov_b32 s30, 2097152
  s_mov_b32 s31, 0x20000
  s_mov_b32 s59, 131072
  buffer_load_dwordx4 v[64:67], v1, s[12:15], s43 offen offset:0 nt
  s_mov_b32 s58, 1048576
  v_mov_b32 v7, 0xffffff00
  v_mov_b32 v25, 1
  v_bfe_i32 v9, v0, 2, 1
  v_not_b32 v8, v9
  v_and_b32 v10, 3, v0
  v_mul_u32_u24 v10, 0x5555, v10
  v_and_b32 v37, 7, v0
  v_lshlrev_b32 v37, 5, v37
  v_and_b32 v38, 16, v0
  v_add_u32 v37, v37, v38
  v_lshrrev_b32 v38, 5, v0
  v_lshl_add_u32 v37, v38, 3, v37
  v_and_b32 v38, 8, v0
  v_lshl_add_u32 v2, v38, 27, v37
  s_and_b32 s42, s37, 7
  s_lshl_b32 s54, s42, 1
  s_lshr_b32 s52, s36, 3
  s_add_u32 s52, s52, s54
  s_mul_i32 s86, s38, 151552
  s_add_u32 s86, s86, 524288
  s_mov_b32 s22, 5308416
  s_mov_b32 s23, 0x20000
  s_mov_b32 s27, 0x20000
  buffer_load_dwordx4 v[68:71], v1, s[12:15], s43 offen offset:1024 nt
  s_add_u32 s43, s43, 16384
  s_and_b32 s43, s43, 65535
  s_or_b32 s43, s43, s92
  s_cmp_eq_u32 s39, 1
  s_cselect_b32 s26, 4718592, s22
  v_lshrrev_b32 v33, 5, v0
  v_bfe_u32 v34, v0, 3, 1
  v_bfe_u32 v35, v0, 4, 1
  v_lshl_add_u32 v36, v34, 1, v35
  v_add_u32 v36, 14, v36
  v_lshl_add_u32 v33, v33, 1, v34
  v_lshl_add_u32 v33, v33, 2, v35
  v_and_b32 v34, 7, v0
  v_lshlrev_b32 v34, 4, v34
  v_and_b32 v35, 32, v0
  v_mul_u32_u24 v5, 1152, v33
  v_lshl_add_u32 v3, v5, 3, v34
  v_add_u32 v5, v5, v34
  v_mul_u32_u24 v6, 1152, v36
  v_lshl_add_u32 v34, v35, 25, v34
  v_lshl_add_u32 v4, v6, 3, v34
  v_add_u32 v6, v6, v34
  s_lshl_b32 s54, s39, 30
  v_or_b32 v6, s54, v6
  v_lshrrev_b32 v31, 3, v0
  v_lshlrev_b32 v31, 4, v31
  v_and_b32 v33, 384, v9
  v_add_u32 v31, v31, v33
  s_mul_i32 s54, s52, 36
  s_mul_i32 s56, s38, 576
  s_add_u32 s54, s54, s56
  s_lshl_b32 s56, s87, 8
  s_lshl_b32 s57, s42, 5
  s_add_u32 s56, s56, s57
  s_cmp_eq_u32 s39, 1
  s_cselect_b32 s54, s56, s54
  s_mul_i32 s46, s54, 1152
  s_lshl_b32 s55, s3, 7
  s_add_u32 s46, s46, s55
  s_mul_i32 s45, s37, 331776
  s_mul_i32 s54, s38, 1152
  s_add_u32 s45, s45, s54
  s_add_u32 s45, s45, s55
  s_mov_b32 s53, 1069066811
  s_xor_b32 s54, s39, 1
  s_lshl_b32 s54, s54, 4
  s_add_u32 s54, s54, s52
  s_mul_i32 s89, s54, 4736
  s_add_u32 s89, s89, s86
  s_lshl_b32 s55, s3, 8
  s_add_u32 s41, s89, s55
  v_bfe_u32 v33, v2, 4, 4
  s_lshl_b32 s55, s3, 4
  v_add_u32 v33, s55, v33
  v_mul_u32_u24 v34, 57, v33
  v_lshrrev_b32 v34, 9, v34
  v_mul_u32_u24 v35, 9, v34
  v_sub_u32 v33, v33, v35
  v_mul_u32_u24 v34, 4736, v34
  v_lshrrev_b32 v35, 1, v33
  v_lshl_add_u32 v34, v35, 10, v34
  v_and_b32 v33, 1, v33
  v_lshl_add_u32 v34, v33, 4, v34
  s_lshl_b32 s54, s37, 6
  s_and_b32 s55, s36, 8
  s_lshl_b32 s55, s55, 2
  s_add_u32 s54, s54, s55
  s_lshr_b32 s55, s54, 1
  v_lshrrev_b32 v35, 2, v35
  v_mul_u32_u24 v35, s55, v35
  v_sub_u32 v34, v34, v35
  v_and_b32 v33, 0x40000008, v2
  v_or_b32 v11, v33, v34
  s_add_u32 s40, s54, s86
  s_add_u32 s40, s40, 75776
  v_mov_b32 v140, 0
  v_mov_b32 v141, 0
  v_mov_b32 v142, 0
  v_mov_b32 v143, 0
  s_waitcnt lgkmcnt(0)
  s_load_dword s47, s[28:29], 0
  s_waitcnt vmcnt(2)
  buffer_load_dwordx4 v[72:75], v1, s[12:15], s43 offen offset:0 nt
  buffer_load_dwordx4 v[76:79], v1, s[12:15], s43 offen offset:1024 nt
  s_add_u32 s43, s43, 16384
  s_and_b32 s43, s43, 65535
  s_or_b32 s43, s43, s92
  s_waitcnt vmcnt(2)
  buffer_load_dwordx4 v[80:83], v1, s[12:15], s43 offen offset:0 nt
  buffer_load_dwordx4 v[84:87], v1, s[12:15], s43 offen offset:1024 nt
  s_waitcnt vmcnt(2)
  buffer_load_dwordx4 v[88:91], v28, s[16:19], s44 offen offset:0 nt
  buffer_load_dwordx4 v[92:95], v28, s[16:19], s44 offen offset:512 nt
  s_add_u32 s44, s44, 16384
  s_and_b32 s44, s44, 65535
  s_or_b32 s44, s44, s92
  s_waitcnt vmcnt(2)
  buffer_load_dwordx4 v[96:99], v28, s[16:19], s44 offen offset:0 nt
  s_mov_b64 exec, 1
  ds_add_u32 v24, v25 offset:12
  s_mov_b64 exec, -1
  buffer_load_dwordx4 v[100:103], v28, s[16:19], s44 offen offset:512 nt
  s_add_u32 s44, s44, 16384
  s_and_b32 s44, s44, 65535
  s_or_b32 s44, s44, s92
  s_waitcnt vmcnt(2)
  buffer_load_dwordx4 v[104:107], v28, s[16:19], s44 offen offset:0 nt
  buffer_load_dwordx4 v[108:111], v28, s[16:19], s44 offen offset:512 nt
  s_add_u32 s44, s44, 16384
  s_and_b32 s44, s44, 65535
  s_or_b32 s44, s44, s92
  s_waitcnt vmcnt(2)
  buffer_load_dwordx4 v[112:115], v28, s[16:19], s44 offen offset:0 nt
  buffer_load_dwordx4 v[116:119], v28, s[16:19], s44 offen offset:512 nt
  buffer_load_dwordx4 v[120:123], v3, s[20:23], s45 offen nt
  s_add_u32 s45, s45, 147456
  v_and_b32 v34, 0xf0, v1
  s_waitcnt lgkmcnt(0)
  s_mov_b32 s93, 0
  s_add_u32 s47, s47, 0x01010108
  s_and_b32 s48, s47, 0xff
  s_bfe_u32 s49, s47, 0x80008
  s_bfe_u32 s50, s47, 0x80010
  s_lshr_b32 s51, s47, 24
  v_lshrrev_b32 v30, 1, v0
  v_and_b32 v30, 16, v30
  v_lshrrev_b32 v30, v30, s47
  v_and_b32 v29, 0xff, v30
  v_bfe_u32 v30, v30, 8, 8
  ds_read_b32 v33, v24 offset:0
  s_waitcnt lgkmcnt(0)
  v_cmp_ne_u32 vcc, 0, v33
  s_cbranch_vccnz L_gotq
  s_waitcnt vmcnt(4)
  buffer_load_dwordx4 v[124:127], v3, s[20:23], s45 offen nt
  s_sub_u32 s45, s45, 129024
  s_mov_b32 s93, 1
  ds_read_b32 v33, v24 offset:0
  s_waitcnt lgkmcnt(0)
  v_cmp_ne_u32 vcc, 0, v33
  s_cbranch_vccnz L_gotq
  s_waitcnt vmcnt(4)
  buffer_load_dwordx4 v[128:131], v3, s[20:23], s45 offen nt
  s_add_u32 s45, s45, 147456
  s_mov_b32 s93, 2
  ds_read_b32 v33, v24 offset:0
  s_waitcnt lgkmcnt(0)
  v_cmp_ne_u32 vcc, 0, v33
  s_cbranch_vccnz L_gotq
  s_waitcnt vmcnt(4)
  buffer_load_dwordx4 v[132:135], v3, s[20:23], s45 offen nt
  s_mov_b32 s93, 3
L_wf1:
  ds_read_b32 v33, v24 offset:0
  s_sub_u32 s58, s58, 1
  s_cbranch_scc1 L_end
  s_waitcnt lgkmcnt(0)
  v_cmp_gt_u32 vcc, 1, v33
  s_cbranch_vccnz L_wf1
L_gotq:
  ds_read_b128 v[48:51], v34 offset:512
  ds_read_b128 v[52:55], v34 offset:768
  ds_read_b32 v38, v24 offset:32
  v_mov_b32 v12, 0
  v_mov_b32 v13, 0
  v_mov_b32 v14, 0
  v_mov_b32 v15, 0
  s_waitcnt lgkmcnt(0)
  v_readfirstlane_b32 s85, v38
  v_dot2_f32_bf16 v33, v56, v48, 0
  v_dot2_f32_bf16 v34, v56, v52, 0
  v_dot2_f32_bf16 v35, v60, v48, 0
  v_dot2_f32_bf16 v36, v60, v52, 0
  v_dot2_f32_bf16 v33, v57, v49, v33
  v_dot2_f32_bf16 v34, v57, v53, v34
  v_dot2_f32_bf16 v35, v61, v49, v35
  v_dot2_f32_bf16 v36, v61, v53, v36
  v_dot2_f32_bf16 v33, v58, v50, v33
  v_dot2_f32_bf16 v34, v58, v54, v34
  v_dot2_f32_bf16 v35, v62, v50, v35
  v_dot2_f32_bf16 v36, v62, v54, v36
  v_dot2_f32_bf16 v33, v59, v51, v33
  v_dot2_f32_bf16 v34, v59, v55, v34
  v_dot2_f32_bf16 v35, v63, v51, v35
  v_dot2_f32_bf16 v36, v63, v55, v36
  v_add_f32_dpp v40, v33, v33 row_ror:8 row_mask:0xf bank_mask:0x3
  s_nop 0
  v_add_f32_dpp v41, v35, v35 row_ror:8 row_mask:0xf bank_mask:0x3
  v_add_f32_dpp v40, v34, v34 row_ror:8 row_mask:0xf bank_mask:0xc
  s_nop 0
  v_add_f32_dpp v41, v36, v36 row_ror:8 row_mask:0xf bank_mask:0xc
  v_dot2_f32_bf16 v33, v64, v48, 0
  v_dot2_f32_bf16 v34, v64, v52, 0
  v_dot2_f32_bf16 v35, v68, v48, 0
  v_dot2_f32_bf16 v36, v68, v52, 0
  v_dot2_f32_bf16 v33, v65, v49, v33
  v_dot2_f32_bf16 v34, v65, v53, v34
  v_dot2_f32_bf16 v35, v69, v49, v35
  v_dot2_f32_bf16 v36, v69, v53, v36
  v_dot2_f32_bf16 v33, v66, v50, v33
  v_dot2_f32_bf16 v34, v66, v54, v34
  v_dot2_f32_bf16 v35, v70, v50, v35
  v_dot2_f32_bf16 v36, v70, v54, v36
  v_dot2_f32_bf16 v33, v67, v51, v33
  v_dot2_f32_bf16 v34, v67, v55, v34
  v_dot2_f32_bf16 v35, v71, v51, v35
  v_dot2_f32_bf16 v36, v71, v55, v36
  v_add_f32_dpp v42, v33, v33 row_ror:8 row_mask:0xf bank_mask:0x3
  s_nop 0
  v_add_f32_dpp v43, v35, v35 row_ror:8 row_mask:0xf bank_mask:0x3
  v_add_f32_dpp v42, v34, v34 row_ror:8 row_mask:0xf bank_mask:0xc
  s_nop 0
  v_add_f32_dpp v43, v36, v36 row_ror:8 row_mask:0xf bank_mask:0xc
  v_dot2_f32_bf16 v33, v72, v48, 0
  v_dot2_f32_bf16 v34, v72, v52, 0
  v_dot2_f32_bf16 v35, v76, v48, 0
  v_dot2_f32_bf16 v36, v76, v52, 0
  v_dot2_f32_bf16 v33, v73, v49, v33
  v_dot2_f32_bf16 v34, v73, v53, v34
  v_dot2_f32_bf16 v35, v77, v49, v35
  v_dot2_f32_bf16 v36, v77, v53, v36
  v_dot2_f32_bf16 v33, v74, v50, v33
  v_dot2_f32_bf16 v34, v74, v54, v34
  v_dot2_f32_bf16 v35, v78, v50, v35
  v_dot2_f32_bf16 v36, v78, v54, v36
  v_dot2_f32_bf16 v33, v75, v51, v33
  v_dot2_f32_bf16 v34, v75, v55, v34
  v_dot2_f32_bf16 v35, v79, v51, v35
  v_dot2_f32_bf16 v36, v79, v55, v36
  v_add_f32_dpp v44, v33, v33 row_ror:8 row_mask:0xf bank_mask:0x3
  s_nop 0
  v_add_f32_dpp v45, v35, v35 row_ror:8 row_mask:0xf bank_mask:0x3
  v_add_f32_dpp v44, v34, v34 row_ror:8 row_mask:0xf bank_mask:0xc
  s_nop 0
  v_add_f32_dpp v45, v36, v36 row_ror:8 row_mask:0xf bank_mask:0xc
  v_dot2_f32_bf16 v33, v80, v48, 0
  v_dot2_f32_bf16 v34, v80, v52, 0
  v_dot2_f32_bf16 v35, v84, v48, 0
  v_dot2_f32_bf16 v36, v84, v52, 0
  v_dot2_f32_bf16 v33, v81, v49, v33
  v_dot2_f32_bf16 v34, v81, v53, v34
  v_dot2_f32_bf16 v35, v85, v49, v35
  v_dot2_f32_bf16 v36, v85, v53, v36
  v_dot2_f32_bf16 v33, v82, v50, v33
  v_dot2_f32_bf16 v34, v82, v54, v34
  v_dot2_f32_bf16 v35, v86, v50, v35
  v_dot2_f32_bf16 v36, v86, v54, v36
  v_dot2_f32_bf16 v33, v83, v51, v33
  v_dot2_f32_bf16 v34, v83, v55, v34
  v_dot2_f32_bf16 v35, v87, v51, v35
  v_dot2_f32_bf16 v36, v87, v55, v36
  v_add_f32_dpp v46, v33, v33 row_ror:8 row_mask:0xf bank_mask:0x3
  s_nop 0
  v_add_f32_dpp v47, v35, v35 row_ror:8 row_mask:0xf bank_mask:0x3
  v_add_f32_dpp v46, v34, v34 row_ror:8 row_mask:0xf bank_mask:0xc
  s_nop 0
  v_add_f32_dpp v47, v36, v36 row_ror:8 row_mask:0xf bank_mask:0xc
  s_cmp_gt_u32 s93, 0
  s_cbranch_scc1 L_skip0
  buffer_load_dwordx4 v[124:127], v3, s[20:23], s45 offen nt
  s_sub_u32 s45, s45, 129024
L_skip0:
  v_add_f32_dpp v40, v40, v40 row_half_mirror row_mask:0xf bank_mask:0xf
  v_add_f32_dpp v41, v41, v41 row_half_mirror row_mask:0xf bank_mask:0xf
  v_add_f32_dpp v42, v42, v42 row_half_mirror row_mask:0xf bank_mask:0xf
  v_add_f32_dpp v43, v43, v43 row_half_mirror row_mask:0xf bank_mask:0xf
  v_add_f32_dpp v44, v44, v44 row_half_mirror row_mask:0xf bank_mask:0xf
  v_add_f32_dpp v45, v45, v45 row_half_mirror row_mask:0xf bank_mask:0xf
  v_add_f32_dpp v46, v46, v46 row_half_mirror row_mask:0xf bank_mask:0xf
  v_add_f32_dpp v47, v47, v47 row_half_mirror row_mask:0xf bank_mask:0xf
  v_add_f32_dpp v40, v40, v40 quad_perm:[1,0,3,2] row_mask:0xf bank_mask:0xf
  v_add_f32_dpp v41, v41, v41 quad_perm:[1,0,3,2] row_mask:0xf bank_mask:0xf
  v_add_f32_dpp v42, v42, v42 quad_perm:[1,0,3,2] row_mask:0xf bank_mask:0xf
  v_add_f32_dpp v43, v43, v43 quad_perm:[1,0,3,2] row_mask:0xf bank_mask:0xf
  v_add_f32_dpp v44, v44, v44 quad_perm:[1,0,3,2] row_mask:0xf bank_mask:0xf
  v_add_f32_dpp v45, v45, v45 quad_perm:[1,0,3,2] row_mask:0xf bank_mask:0xf
  v_add_f32_dpp v46, v46, v46 quad_perm:[1,0,3,2] row_mask:0xf bank_mask:0xf
  v_add_f32_dpp v47, v47, v47 quad_perm:[1,0,3,2] row_mask:0xf bank_mask:0xf
  v_add_f32_dpp v40, v40, v40 quad_perm:[2,3,0,1] row_mask:0xf bank_mask:0xf
  v_add_f32_dpp v41, v41, v41 quad_perm:[2,3,0,1] row_mask:0xf bank_mask:0xf
  v_add_f32_dpp v42, v42, v42 quad_perm:[2,3,0,1] row_mask:0xf bank_mask:0xf
  v_add_f32_dpp v43, v43, v43 quad_perm:[2,3,0,1] row_mask:0xf bank_mask:0xf
  v_add_f32_dpp v44, v44, v44 quad_perm:[2,3,0,1] row_mask:0xf bank_mask:0xf
  v_add_f32_dpp v45, v45, v45 quad_perm:[2,3,0,1] row_mask:0xf bank_mask:0xf
  v_add_f32_dpp v46, v46, v46 quad_perm:[2,3,0,1] row_mask:0xf bank_mask:0xf
  v_add_f32_dpp v47, v47, v47 quad_perm:[2,3,0,1] row_mask:0xf bank_mask:0xf
  s_mov_b32 s54, 1035273459
  v_cvt_pk_bf16_f32 v40, 0, v40
  v_cvt_pk_bf16_f32 v41, 0, v41
  v_cvt_pk_bf16_f32 v42, 0, v42
  v_cvt_pk_bf16_f32 v43, 0, v43
  v_cvt_pk_bf16_f32 v44, 0, v44
  v_cvt_pk_bf16_f32 v45, 0, v45
  v_cvt_pk_bf16_f32 v46, 0, v46
  v_cvt_pk_bf16_f32 v47, 0, v47
  v_mul_f32 v40, s54, v40
  v_mul_f32 v41, s54, v41
  v_mul_f32 v42, s54, v42
  v_mul_f32 v43, s54, v43
  v_mul_f32 v44, s54, v44
  v_mul_f32 v45, s54, v45
  v_mul_f32 v46, s54, v46
  v_mul_f32 v47, s54, v47
  v_cvt_pk_bf16_f32 v40, 0, v40
  v_cvt_pk_bf16_f32 v41, 0, v41
  v_cvt_pk_bf16_f32 v42, 0, v42
  v_cvt_pk_bf16_f32 v43, 0, v43
  v_cvt_pk_bf16_f32 v44, 0, v44
  v_cvt_pk_bf16_f32 v45, 0, v45
  v_cvt_pk_bf16_f32 v46, 0, v46
  v_cvt_pk_bf16_f32 v47, 0, v47
  v_max3_f32 v38, v40, v41, v42
  v_max3_f32 v33, v43, v44, v45
  v_max3_f32 v38, v38, v46, v47
  v_max_f32 v38, v38, v33
  v_mov_b32 v33, v38
  s_nop 1
  v_permlane32_swap_b32 v38, v33
  v_max_f32 v38, v38, v33
  v_mov_b32 v33, v38
  s_nop 1
  v_permlane16_swap_b32 v38, v33
  v_max_f32 v38, v38, v33
  v_mul_f32 v33, s53, v38
  v_fma_f32 v40, v40, s53, -v33
  v_fma_f32 v41, v41, s53, -v33
  v_fma_f32 v42, v42, s53, -v33
  v_fma_f32 v43, v43, s53, -v33
  v_fma_f32 v44, v44, s53, -v33
  v_fma_f32 v45, v45, s53, -v33
  v_fma_f32 v46, v46, s53, -v33
  v_fma_f32 v47, v47, s53, -v33
  v_exp_f32 v40, v40
  v_exp_f32 v41, v41
  v_exp_f32 v42, v42
  v_exp_f32 v43, v43
  v_exp_f32 v44, v44
  v_exp_f32 v45, v45
  v_exp_f32 v46, v46
  v_exp_f32 v47, v47
  s_cmp_gt_u32 s93, 1
  s_cbranch_scc1 L_skip1
  buffer_load_dwordx4 v[128:131], v3, s[20:23], s45 offen nt
  s_add_u32 s45, s45, 147456
L_skip1:
  s_cmp_gt_u32 s93, 2
  s_cbranch_scc1 L_skip2
  buffer_load_dwordx4 v[132:135], v3, s[20:23], s45 offen nt
L_skip2:
  v_add_f32 v39, v40, v41
  v_add_f32 v33, v42, v43
  v_add_f32 v34, v44, v45
  v_add_f32 v35, v46, v47
  v_add_f32 v39, v39, v33
  v_add_f32 v34, v34, v35
  v_add_f32 v39, v39, v34
  v_cvt_pk_bf16_f32 v40, v40, 0
  v_cvt_pk_bf16_f32 v41, v41, 0
  v_cvt_pk_bf16_f32 v42, v42, 0
  v_cvt_pk_bf16_f32 v43, v43, 0
  v_cvt_pk_bf16_f32 v44, v44, 0
  v_cvt_pk_bf16_f32 v45, v45, 0
  v_cvt_pk_bf16_f32 v46, v46, 0
  v_cvt_pk_bf16_f32 v47, v47, 0
  v_mov_b32 v33, v39
  s_nop 1
  v_permlane32_swap_b32 v39, v33
  v_add_f32 v39, v39, v33
  v_mov_b32 v33, v39
  s_nop 1
  v_permlane16_swap_b32 v39, v33
  v_add_f32 v39, v39, v33
  v_and_b32 v33, 8, v0
  v_lshlrev_b32 v33, 3, v33
  s_lshl_b32 s54, s3, 3
  v_add_u32 v33, s54, v33
  ds_write_b64 v33, v[38:39] offset:1024
  v_mov_b32 v76, 0
  v_mov_b32 v77, 0
  v_mov_b32 v78, 0
  v_mov_b32 v79, 0
  v_and_b32 v33, 15, v0
  v_lshlrev_b32 v33, 5, v33
  v_and_b32 v34, 16, v0
  v_add_u32 v33, v33, v34
  v_and_b32 v34, 32, v0
  v_lshl_add_u32 v33, v34, 4, v33
  s_lshl_b32 s54, s3, 10
  v_add_u32 v33, s54, v33
  v_and_b32 v16, v40, v8
  v_and_b32 v17, v40, v9
  v_and_b32 v18, v41, v8
  v_and_b32 v19, v41, v9
  s_nop 1
  v_smfmac_f32_16x16x64_bf16 v[12:15], v[16:19], v[88:95], v10
  v_and_b32 v20, v42, v8
  v_and_b32 v21, v42, v9
  v_and_b32 v22, v43, v8
  v_and_b32 v23, v43, v9
  s_nop 1
  v_smfmac_f32_16x16x64_bf16 v[12:15], v[20:23], v[96:103], v10
  v_and_b32 v16, v44, v8
  v_and_b32 v17, v44, v9
  v_and_b32 v18, v45, v8
  v_and_b32 v19, v45, v9
  s_waitcnt vmcnt(7)
  s_waitcnt vmcnt(6)
  v_smfmac_f32_16x16x64_bf16 v[12:15], v[16:19], v[104:111], v10
  v_and_b32 v20, v46, v8
  v_and_b32 v21, v46, v9
  v_and_b32 v22, v47, v8
  v_and_b32 v23, v47, v9
  s_waitcnt vmcnt(5)
  s_waitcnt vmcnt(4)
  v_smfmac_f32_16x16x64_bf16 v[12:15], v[20:23], v[112:119], v10
  s_nop 7
  ds_write_b128 v33, v[12:15] offset:3584
  s_mov_b64 exec, 1
  ds_add_u32 v24, v25 offset:4
  s_mov_b64 exec, -1
  ds_read_b128 v[88:91], v1 offset:11776
  ds_read_b128 v[92:95], v1 offset:12800
  ds_read_b128 v[96:99], v1 offset:13824
  s_cmp_eq_u32 s39, 1
  s_cselect_b32 s54, 6, 4
  s_cselect_b32 s55, 2, 5
  s_cselect_b32 s91, s89, 1073741824
  s_sub_u32 s42, s3, s54
  s_lshl_b32 s54, s42, 10
  s_add_u32 s90, s89, s54
  s_cmp_lt_u32 s42, s55
  s_cselect_b32 s90, s90, 1073741824
  s_cselect_b32 s91, s91, 1073741824
  s_cselect_b32 s42, s42, 9
  s_cmp_eq_u32 s42, 4
  s_cselect_b32 s54, 1, 0
  s_cselect_b32 s57, 16, 128
  v_lshrrev_b32 v48, s54, v0
  v_lshlrev_b32 v48, 4, v48
  v_lshrrev_b32 v51, 2, v0
  v_lshlrev_b32 v51, 4, v51
  s_cselect_b32 s55, 8, s42
  s_cselect_b32 s54, 0, -1
  s_add_u32 s56, s39, 5
  s_lshl_b32 s55, s55, s56
  s_bfm_b32 s56, s56, 0
  s_and_b32 s56, s56, s54
  v_and_b32 v49, s56, v1
  v_add_u32 v49, s55, v49
  v_bfe_u32 v35, v0, 4, 1
  v_mul_u32_u24 v35, s57, v35
  v_add_u32 v49, v49, v35
  v_lshrrev_b32 v35, 5, v0
  v_lshl_add_u32 v49, v35, 3, v49
  v_and_b32 v35, 388, v9
  v_add_u32 v49, v49, v35
  s_lshl_b32 s54, s39, 1
  s_xor_b32 s54, s54, 2
  v_and_b32 v35, s54, v0
  v_cmp_eq_u32 vcc, 0, v35
  v_mov_b32 v35, 800
  s_nop 0
  v_cndmask_b32 v49, v35, v49, vcc
  s_waitcnt lgkmcnt(0)
  v_mov_b32 v12, 0
  v_mov_b32 v13, 0
  v_mov_b32 v14, 0
  v_mov_b32 v15, 0
  s_waitcnt vmcnt(3)
  buffer_load_dwordx4 v[136:139], v4, s[20:23], s45 offen nt
  s_waitcnt vmcnt(3)
  v_smfmac_f32_16x16x64_bf16 v[12:15], v[88:91], v[120:127], v10
  s_waitcnt vmcnt(2)
  buffer_load_dwordx4 v[56:59], v5, s[24:27], s46 offen nt
  s_add_u32 s46, s46, 18432
  s_waitcnt vmcnt(2)
  buffer_load_dwordx4 v[60:63], v5, s[24:27], s46 offen nt
  s_sub_u32 s46, s46, 16128
  v_smfmac_f32_16x16x64_bf16 v[12:15], v[92:95], v[128:135], v10
  s_waitcnt vmcnt(2)
  v_smfmac_f32_16x16x64_bf16 v[12:15], v[96:99], v[136:143], v10
  s_cmp_lg_u32 s85, 0
  s_nop 6
  v_permlane32_swap_b32 v12, v14
  v_permlane32_swap_b32 v13, v15
  s_nop 0
  v_add_f32_dpp v12, v14, v12 row_ror:8 row_mask:0xf bank_mask:0xf
  v_add_f32_dpp v13, v15, v13 row_ror:8 row_mask:0xf bank_mask:0xf
  v_and_or_b32 v12, v12, v7, v29
  v_and_or_b32 v13, v13, v7, v30
  s_cbranch_scc1 L_ps2
  buffer_store_dwordx2 v[12:13], v11, s[28:31], s40 offen
  s_branch L_pe2
L_ps2:
  buffer_store_dwordx2 v[12:13], v11, s[28:31], s40 offen sc1
L_pe2:
  s_mov_b64 exec, 1
  ds_add_u32 v24, v25 offset:12
  s_mov_b64 exec, -1
L_eg:
  s_lshl3_add_u32 s54, s39, s42
  s_cmp_ge_u32 s54, 5
  s_cbranch_scc1 L_egl
L_wf3:
  ds_read_b32 v33, v24 offset:12
  s_sub_u32 s58, s58, 1
  s_cbranch_scc1 L_end
  s_waitcnt lgkmcnt(0)
  v_cmp_gt_u32 vcc, 16, v33
  s_cbranch_vccnz L_wf3
L_egl:
  buffer_load_dwordx4 v[44:47], v51, s[28:31], s91 offen offset:2048 sc1 nt
  buffer_load_dwordx4 v[40:43], v48, s[28:31], s90 offen sc1 nt
  buffer_load_dwordx4 v[64:67], v5, s[24:27], s46 offen nt
  s_add_u32 s46, s46, 18432
  buffer_load_dwordx4 v[68:71], v5, s[24:27], s46 offen nt
  s_waitcnt vmcnt(6)
  buffer_load_dwordx4 v[72:75], v6, s[24:27], s46 offen nt
  v_mov_b32 v12, 0
  v_mov_b32 v13, 0
  v_mov_b32 v14, 0
  v_mov_b32 v15, 0
  v_xor_b32 v29, 0x80, v29
  v_xor_b32 v30, 0x80, v30
  s_cmp_eq_u32 s42, 9
  s_cbranch_scc1 L_b4
  v_mov_b32 v38, 0xC0135761
  s_waitcnt vmcnt(3)
  s_cmp_eq_u32 s39, 1
  s_cbranch_scc1 L_chkh2
  s_branch L_chkhh
L_pollhh:
  s_waitcnt vmcnt(1)
  buffer_load_dwordx4 v[40:43], v48, s[28:31], s90 offen sc1 nt
  s_sub_u32 s59, s59, 1
  s_cbranch_scc1 L_end
  s_waitcnt vmcnt(0)
L_chkhh:
  v_xor_b32 v40, s48, v40
  v_xor_b32 v41, s49, v41
  v_xor_b32 v42, s50, v42
  v_xor_b32 v43, s51, v43
  v_or3_b32 v44, v40, v41, v42
  v_or_b32 v44, v44, v43
  v_permlane32_swap_b32 v40, v41
  v_permlane32_swap_b32 v42, v43
  v_add_f32 v40, v40, v41
  v_add_f32 v42, v42, v43
  v_cmp_ne_u32_sdwa vcc, v44, v24 src0_sel:BYTE_0 src1_sel:DWORD
  s_nop 0
  v_permlane16_swap_b32 v40, v42
  v_add_f32 v39, v40, v42
  s_cbranch_vccnz L_pollhh
L_okh:
  s_nop 0
  v_add_f32_dpp v40, v39, v39 row_ror:4 row_mask:0xf bank_mask:0xf
  s_nop 1
  v_add_f32_dpp v40, v40, v40 row_ror:8 row_mask:0xf bank_mask:0xf
  v_cvt_pk_bf16_f32 v40, 0, v40
  v_mul_f32 v42, v40, v40
  v_fmac_f32 v38, 0xBDD2D3E8, v42
  v_mul_f32 v42, v38, v40
  v_exp_f32 v42, v42
  s_nop 0
  v_add_f32 v42, 1.0, v42
  v_rcp_f32 v42, v42
  s_nop 0
  v_mul_f32 v42, v42, v40
  v_cvt_pk_bf16_f32 v42, 0, v42
  s_nop 1
  v_mul_f32_dpp v42, v40, v42 quad_perm:[2,3,0,1] row_mask:0xf bank_mask:0xf
  v_cvt_pk_bf16_f32 v42, v42, 0
  ds_write_b32 v49, v42 offset:2560
L_b4:
  s_waitcnt lgkmcnt(0)
  s_barrier
  ds_read_b128 v[88:91], v31 offset:2560
  ds_read_b128 v[92:95], v31 offset:2688
  ds_read_b128 v[96:99], v31 offset:2816
  s_cmp_lg_u32 s85, 0
  s_waitcnt vmcnt(3) lgkmcnt(2)
  v_smfmac_f32_16x16x64_bf16 v[12:15], v[88:91], v[56:63], v10
  s_waitcnt vmcnt(1) lgkmcnt(1)
  v_smfmac_f32_16x16x64_bf16 v[12:15], v[92:95], v[64:71], v10
  s_waitcnt vmcnt(0) lgkmcnt(0)
  v_smfmac_f32_16x16x64_bf16 v[12:15], v[96:99], v[72:79], v10
  s_nop 7
  v_permlane32_swap_b32 v12, v14
  v_permlane32_swap_b32 v13, v15
  s_nop 0
  v_add_f32_dpp v12, v14, v12 row_ror:8 row_mask:0xf bank_mask:0xf
  v_add_f32_dpp v13, v15, v13 row_ror:8 row_mask:0xf bank_mask:0xf
  v_and_or_b32 v12, v12, v7, v29
  v_and_or_b32 v13, v13, v7, v30
  s_cbranch_scc1 L_ps4
  buffer_store_dwordx2 v[12:13], v2, s[28:31], s41 offen
  s_branch L_pe4
L_ps4:
  buffer_store_dwordx2 v[12:13], v2, s[28:31], s41 offen sc1
L_pe4:
  s_endpgm
L_pollh2:
  s_waitcnt vmcnt(3)
  buffer_load_dwordx4 v[44:47], v51, s[28:31], s91 offen offset:2048 sc1 nt
  buffer_load_dwordx4 v[40:43], v48, s[28:31], s90 offen sc1 nt
  s_sub_u32 s59, s59, 1
  s_cbranch_scc1 L_end
  s_waitcnt vmcnt(0)
L_chkh2:
  v_xor_b32 v44, s48, v44
  v_xor_b32 v45, s49, v45
  v_xor_b32 v46, s50, v46
  v_xor_b32 v47, s51, v47
  v_xor_b32 v40, s48, v40
  v_xor_b32 v41, s49, v41
  v_xor_b32 v42, s50, v42
  v_xor_b32 v43, s51, v43
  v_max_f32_dpp v36, v44, v44 row_ror:4 row_mask:0xf bank_mask:0xf
  v_or3_b32 v38, v44, v45, v46
  v_or3_b32 v38, v38, v47, v40
  v_max_f32_dpp v36, v36, v36 row_ror:8 row_mask:0xf bank_mask:0xf
  v_mov_b32 v37, v36
  v_or3_b32 v38, v38, v41, v42
  v_or_b32 v38, v38, v43
  v_permlane32_swap_b32 v36, v37
  v_max_f32 v36, v36, v37
  v_mov_b32 v37, v36
  v_cmp_ne_u32_sdwa vcc, v38, v24 src0_sel:BYTE_0 src1_sel:DWORD
  s_nop 0
  v_permlane16_swap_b32 v36, v37
  v_max_f32 v36, v36, v37
  s_cbranch_vccnz L_pollh2
  v_mul_f32 v36, s53, v36
  v_fma_f32 v36, v44, s53, -v36
  v_exp_f32 v36, v36
  s_nop 0
  v_mul_f32 v45, v45, v36
  v_mul_f32 v40, v40, v36
  v_mul_f32 v41, v41, v36
  v_mov_b32 v37, v45
  v_mul_f32 v42, v42, v36
  v_mul_f32 v43, v43, v36
  v_permlane32_swap_b32 v45, v37
  v_permlane32_swap_b32 v40, v41
  v_permlane32_swap_b32 v42, v43
  v_add_f32 v45, v45, v37
  v_mov_b32 v37, v45
  v_add_f32 v40, v40, v41
  v_add_f32 v42, v42, v43
  v_permlane16_swap_b32 v45, v37
  v_add_f32 v45, v45, v37
  v_permlane16_swap_b32 v40, v42
  v_add_f32 v40, v40, v42
  v_add_f32_dpp v45, v45, v45 row_ror:4 row_mask:0xf bank_mask:0xf
  s_nop 0
  v_add_f32_dpp v40, v40, v40 row_ror:4 row_mask:0xf bank_mask:0xf
  v_add_f32_dpp v45, v45, v45 row_ror:8 row_mask:0xf bank_mask:0xf
  v_rcp_f32 v45, v45
  v_add_f32_dpp v40, v40, v40 row_ror:8 row_mask:0xf bank_mask:0xf
  v_mul_f32 v40, v40, v45
  v_cvt_pk_bf16_f32 v40, v40, 0
  ds_write_b32 v49, v40 offset:2560
  s_branch L_b4
L_x:
  s_lshr_b32 s39, s2, 7
  s_and_b32 s54, s2, 8
  s_add_u32 s54, s54, 48
  s_lshl_b32 s55, s39, 5
  s_sub_u32 s55, 64, s55
  s_load_dwordx2 s[20:21], s[0:1], s54
  s_load_dwordx2 s[24:25], s[0:1], s55
  s_load_dwordx2 s[32:33], s[0:1], 72
  s_load_dword s47, s[28:29], 0
  v_mov_b32 v76, 0
  v_mov_b32 v77, 0
  v_mov_b32 v78, 0
  v_mov_b32 v79, 0
  v_mov_b32 v24, 0
  ds_write_b128 v1, v[76:79] offset:2560
  s_and_b32 s38, s2, 7
  s_mov_b32 s30, 2097152
  s_mov_b32 s31, 0x20000
  s_mov_b32 s59, 131072
  s_mov_b32 s58, 1048576
  v_mov_b32 v7, 0xffffff00
  v_mov_b32 v25, 1
  v_bfe_i32 v9, v0, 2, 1
  v_not_b32 v8, v9
  v_and_b32 v10, 3, v0
  v_mul_u32_u24 v10, 0x5555, v10
  v_and_b32 v37, 7, v0
  v_lshlrev_b32 v37, 5, v37
  v_and_b32 v38, 16, v0
  v_add_u32 v37, v37, v38
  v_lshrrev_b32 v38, 5, v0
  v_lshl_add_u32 v37, v38, 3, v37
  v_and_b32 v38, 8, v0
  v_lshl_add_u32 v2, v38, 27, v37
  s_and_b32 s42, s37, 7
  s_lshl_b32 s54, s42, 1
  s_lshr_b32 s52, s36, 3
  s_add_u32 s52, s52, s54
  s_mul_i32 s86, s38, 151552
  s_add_u32 s86, s86, 524288
  v_mov_b32 v12, 0
  v_mov_b32 v13, 0
  v_mov_b32 v14, 0
  v_mov_b32 v15, 0
  v_cmp_gt_u32 vcc, 32, v0
  s_waitcnt vmcnt(7)
  v_lshlrev_b32 v94, 16, v88
  v_and_b32 v95, 0xffff0000, v88
  v_lshlrev_b32 v96, 16, v89
  v_and_b32 v97, 0xffff0000, v89
  v_lshlrev_b32 v98, 16, v90
  v_and_b32 v99, 0xffff0000, v90
  v_lshlrev_b32 v100, 16, v91
  v_and_b32 v101, 0xffff0000, v91
  v_lshlrev_b32 v102, 16, v92
  v_and_b32 v103, 0xffff0000, v92
  v_add_f32 v33, v94, v95
  v_add_f32 v34, v96, v97
  v_add_f32 v35, v98, v99
  v_add_f32 v37, v100, v101
  v_add_f32 v33, v33, v102
  v_add_f32 v34, v34, v103
  v_add_f32 v35, v35, v37
  v_add_f32 v33, v33, v34
  v_add_f32 v33, v33, v35
  s_nop 1
  v_add_f32_dpp v33, v33, v33 row_ror:8 row_mask:0xf bank_mask:0xf
  s_nop 1
  v_add_f32_dpp v33, v33, v33 row_ror:4 row_mask:0xf bank_mask:0xf
  s_nop 1
  v_add_f32_dpp v33, v33, v33 row_ror:2 row_mask:0xf bank_mask:0xf
  s_nop 1
  v_add_f32_dpp v33, v33, v33 row_ror:1 row_mask:0xf bank_mask:0xf
  s_nop 1
  v_add_f32_dpp v33, v33, v33 row_bcast:15 row_mask:0xa bank_mask:0xf
  s_nop 1
  v_add_f32_dpp v33, v33, v33 row_bcast:31 row_mask:0xc bank_mask:0xf
  s_nop 0
  v_readlane_b32 s54, v33, 63
  v_mov_b32 v34, 0x3AE38E39
  s_nop 0
  v_mul_f32 v31, s54, v34
  v_sub_f32 v94, v94, v31
  v_sub_f32 v95, v95, v31
  v_sub_f32 v96, v96, v31
  v_sub_f32 v97, v97, v31
  v_sub_f32 v98, v98, v31
  v_sub_f32 v99, v99, v31
  v_sub_f32 v100, v100, v31
  v_sub_f32 v101, v101, v31
  v_sub_f32 v102, v102, v31
  v_sub_f32 v103, v103, v31
  v_cndmask_b32 v102, 0, v102, vcc
  v_cndmask_b32 v103, 0, v103, vcc
  v_mul_f32 v33, v94, v94
  v_mul_f32 v35, v95, v95
  v_fmac_f32 v33, v96, v96
  v_fmac_f32 v35, v97, v97
  v_fmac_f32 v33, v98, v98
  v_fmac_f32 v35, v99, v99
  v_fmac_f32 v33, v100, v100
  v_fmac_f32 v35, v101, v101
  v_fmac_f32 v33, v102, v102
  v_fmac_f32 v35, v103, v103
  v_add_f32 v33, v33, v35
  s_nop 1
  v_add_f32_dpp v33, v33, v33 row_ror:8 row_mask:0xf bank_mask:0xf
  s_nop 1
  v_add_f32_dpp v33, v33, v33 row_ror:4 row_mask:0xf bank_mask:0xf
  s_nop 1
  v_add_f32_dpp v33, v33, v33 row_ror:2 row_mask:0xf bank_mask:0xf
  s_nop 1
  v_add_f32_dpp v33, v33, v33 row_ror:1 row_mask:0xf bank_mask:0xf
  s_nop 1
  v_add_f32_dpp v33, v33, v33 row_bcast:15 row_mask:0xa bank_mask:0xf
  s_nop 1
  v_add_f32_dpp v33, v33, v33 row_bcast:31 row_mask:0xc bank_mask:0xf
  s_nop 0
  v_readlane_b32 s54, v33, 63
  v_cvt_pk_bf16_f32 v31, 0, v31
  s_nop 0
  v_mul_f32 v32, s54, v34
  v_cvt_pk_bf16_f32 v32, 0, v32
  v_add_f32 v32, 0x3727C5AC, v32
  v_cvt_pk_bf16_f32 v32, 0, v32
  v_sqrt_f32 v32, v32
  s_nop 0
  v_cvt_pk_bf16_f32 v32, 0, v32
  v_rcp_f32 v32, v32
  s_waitcnt vmcnt(5)
  v_lshlrev_b32 v40, 16, v104
  v_and_b32 v41, 0xffff0000, v104
  v_lshlrev_b32 v42, 16, v105
  v_and_b32 v43, 0xffff0000, v105
  v_lshlrev_b32 v44, 16, v106
  v_and_b32 v45, 0xffff0000, v106
  v_sub_f32 v40, v40, v31
  v_sub_f32 v41, v41, v31
  v_sub_f32 v42, v42, v31
  v_sub_f32 v43, v43, v31
  v_sub_f32 v44, v44, v31
  v_sub_f32 v45, v45, v31
  v_cvt_pk_bf16_f32 v40, 0, v40
  v_cvt_pk_bf16_f32 v41, 0, v41
  v_cvt_pk_bf16_f32 v42, 0, v42
  v_cvt_pk_bf16_f32 v43, 0, v43
  v_cvt_pk_bf16_f32 v44, 0, v44
  v_cvt_pk_bf16_f32 v45, 0, v45
  v_mul_f32 v40, v40, v32
  v_mul_f32 v41, v41, v32
  v_mul_f32 v42, v42, v32
  v_mul_f32 v43, v43, v32
  v_mul_f32 v44, v44, v32
  v_mul_f32 v45, v45, v32
  v_cvt_pk_bf16_f32 v40, v40, 0
  v_cvt_pk_bf16_f32 v41, v41, 0
  v_cvt_pk_bf16_f32 v42, v42, 0
  v_cvt_pk_bf16_f32 v43, v43, 0
  v_cvt_pk_bf16_f32 v44, v44, 0
  v_cvt_pk_bf16_f32 v45, v45, 0
  v_and_b32 v88, v40, v8
  v_and_b32 v89, v40, v9
  v_and_b32 v90, v41, v8
  v_and_b32 v91, v41, v9
  v_and_b32 v92, v42, v8
  v_and_b32 v93, v42, v9
  v_and_b32 v94, v43, v8
  v_and_b32 v95, v43, v9
  v_and_b32 v96, v44, v8
  v_and_b32 v97, v44, v9
  v_and_b32 v98, v45, v8
  v_and_b32 v99, v45, v9
  s_cmp_lg_u32 s43, s44
  s_cbranch_scc1 L_noxn
  ds_write_b128 v1, v[88:91] offset:11776
  ds_write_b128 v1, v[92:95] offset:12800
  ds_write_b128 v1, v[96:99] offset:13824
L_noxn:
  s_waitcnt vmcnt(3)
  v_smfmac_f32_16x16x64_bf16 v[12:15], v[88:91], v[56:63], v10
  s_waitcnt vmcnt(1)
  v_smfmac_f32_16x16x64_bf16 v[12:15], v[92:95], v[64:71], v10
  s_waitcnt vmcnt(0)
  v_smfmac_f32_16x16x64_bf16 v[12:15], v[96:99], v[72:79], v10
  s_lshl_b32 s54, s3, 8
  v_add_u32 v37, s54, v2
  v_min_u32 v37, 1024, v37
  s_nop 4
  v_permlane32_swap_b32 v12, v14
  v_permlane32_swap_b32 v13, v15
  s_nop 0
  v_add_f32_dpp v12, v14, v12 row_ror:8 row_mask:0xf bank_mask:0xf
  v_add_f32_dpp v13, v15, v13 row_ror:8 row_mask:0xf bank_mask:0xf
  ds_write_b64 v37, v[12:13] offset:1280
  s_mov_b64 exec, 1
  ds_add_u32 v24, v25 offset:8
  s_mov_b64 exec, -1
  s_waitcnt lgkmcnt(0)
  s_add_u32 s47, s47, 0x01010108
  s_and_b32 s48, s47, 0xff
  s_bfe_u32 s49, s47, 0x80008
  s_bfe_u32 s50, s47, 0x80010
  s_lshr_b32 s51, s47, 24
  s_cmp_eq_u32 s3, 3
  s_cbranch_scc1 L_x3
  s_setprio 0
  s_xor_b32 s54, s39, 1
  s_lshl4_add_u32 s54, s54, s52
  s_mul_i32 s88, s54, 3
  s_add_u32 s88, s88, s3
  s_and_b32 s99, s47, 0x7ffff8
  s_or_b32 s99, s99, 0x4b000000
  s_cmp_ge_u32 s88, 72
  s_cbranch_scc1 L_fin
  s_mov_b32 s34, 1152
  s_mov_b32 s35, 0x20000
  v_lshrrev_b32 v48, 1, v0
  v_mul_u32_u24 v48, 4736, v48
  v_and_b32 v33, 1, v0
  v_lshl_add_u32 v48, v33, 4, v48
  s_lshl_b32 s89, s88, 5
  s_add_u32 s89, s89, s86
  v_and_b32 v33, 15, v0
  v_lshlrev_b32 v33, 2, v33
  v_bfe_u32 v36, v0, 4, 1
  v_lshrrev_b32 v37, 5, v0
  v_lshl_add_u32 v36, v36, 1, v37
  v_add_u32 v33, v33, v36
  v_lshlrev_b32 v51, 1, v33
  s_lshl_b32 s93, s88, 4
  buffer_load_ushort v52, v51, s[4:7], s93 offen
  v_mov_b32 v35, 1073741824
  v_lshlrev_b32 v49, 2, v33
  v_cmp_gt_u32 vcc, 8, v33
  v_cmp_gt_u32 s[54:55], 9, v33
  v_cmp_eq_u32 s[96:97], 8, v33
  v_cndmask_b32 v51, v35, v51, vcc
  v_cndmask_b32 v49, v35, v49, s[54:55]
  s_lshl_b32 s94, s88, 7
  s_add_u32 s94, s94, 32768
  v_mov_b32 v53, 1.0
  v_lshlrev_b32 v54, 2, v0
  v_and_b32 v33, 32, v0
  v_lshl_add_u32 v54, v33, 25, v54
  s_xor_b32 s48, s48, 0x80
  s_xor_b32 s49, s49, 0x80
  s_xor_b32 s50, s50, 0x80
  s_xor_b32 s51, s51, 0x80
  s_and_b32 s54, s88, 7
  s_cmp_lg_u32 s54, s38
  s_cbranch_scc1 L_rb4
  v_cmp_eq_u32 vcc, 8, v0
  v_mov_b32 v56, s99
  s_nop 0
  v_cndmask_b32 v56, 0, v56, vcc
  buffer_store_dword v56, v54, s[28:31], s94 offen sc1
  s_load_dword s57, s[32:33], s93 glc
  s_waitcnt lgkmcnt(0)
L_rb4:
  s_waitcnt vmcnt(0)
  v_lshlrev_b32 v52, 16, v52
  s_barrier
L_polla:
  buffer_load_dwordx4 v[40:43], v48, s[28:31], s89 offen sc1 nt
  s_sub_u32 s59, s59, 1
  s_cbranch_scc1 L_end
  s_waitcnt vmcnt(0)
  v_xor_b32 v40, s48, v40
  v_xor_b32 v41, s49, v41
  v_xor_b32 v42, s50, v42
  v_xor_b32 v43, s51, v43
  v_or3_b32 v39, v40, v41, v42
  v_or_b32 v39, v39, v43
  v_permlane32_swap_b32 v40, v41
  v_permlane32_swap_b32 v42, v43
  v_add_f32 v40, v40, v41
  v_add_f32 v42, v42, v43
  v_cmp_ne_u32_sdwa vcc, v39, v24 src0_sel:BYTE_0 src1_sel:DWORD
  s_nop 0
  v_permlane16_swap_b32 v40, v42
  v_add_f32 v44, v40, v42
  s_cbranch_vccnz L_polla
L_oka:
  s_nop 0
  v_add_f32_dpp v41, v44, v44 quad_perm:[2,3,0,1] row_mask:0xf bank_mask:0xf
  s_nop 1
  v_add_f32_dpp v41, v41, v41 row_ror:4 row_mask:0xf bank_mask:0xf
  s_nop 1
  v_add_f32_dpp v41, v41, v41 row_ror:8 row_mask:0xf bank_mask:0xf
L_add:
  v_cndmask_b32 v42, v41, v53, s[96:97]
  buffer_atomic_add_f32 v42, v49, s[28:31], s94 offen sc0 sc1
  v_add_f32 v43, v41, v52
  s_waitcnt vmcnt(0)
  v_readlane_b32 s54, v42, 2
  v_add_f32 v43, v43, v42
  v_cvt_pk_bf16_f32 v43, v43, 0
  s_xor_b32 s54, s54, s99
  s_cmp_lg_u32 s54, 7
  s_cbranch_scc1 L_notlast
  buffer_store_short v43, v51, s[32:35], s93 offen
  s_cmp_lg_u32 s88, 0
  s_cbranch_scc1 L_fin
  v_mov_b32 v40, s47
  buffer_store_dword v40, v54, s[28:31], 0 offen
  s_endpgm
L_notlast:
  s_cmp_lt_u32 s54, 8
  s_cbranch_scc1 L_fin
  s_add_u32 s55, s94, 32
L_claim:
  s_load_dword s54, s[28:29], s55 glc
  s_sub_u32 s59, s59, 1
  s_cbranch_scc1 L_end
  s_waitcnt lgkmcnt(0)
  s_xor_b32 s54, s54, s99
  s_cmp_lt_u32 s54, 8
  s_cbranch_scc0 L_claim
  s_branch L_add
L_x3:
  s_getreg_b32 s55, hwreg(HW_REG_XCC_ID, 0, 3)
  s_mul_i32 s54, s36, 8192
  s_add_u32 s54, s54, 262144
  s_mul_i32 s40, s37, 512
  s_add_u32 s40, s40, s54
  s_xor_b32 s43, s54, 65536
  s_and_b32 s41, s48, 0xf8
  s_or_b32 s41, s41, s55
  v_and_b32 v34, 511, v1
  v_lshrrev_b32 v36, 5, v0
  v_lshl_add_u32 v36, v36, 28, v1
  v_and_b32 v37, 15, v0
  v_mul_u32_u24 v37, 512, v37
  s_mov_b32 s85, 0
L_wf5:
  ds_read_b32 v33, v24 offset:8
  s_sub_u32 s58, s58, 1
  s_cbranch_scc1 L_end
  s_waitcnt lgkmcnt(0)
  v_cmp_gt_u32 vcc, 4, v33
  s_cbranch_vccnz L_wf5
  ds_read_b128 v[12:15], v34 offset:1280
  ds_read_b128 v[60:63], v34 offset:1792
  s_add_u32 s55, s54, 4096
  s_waitcnt lgkmcnt(0)
  v_add_f32 v12, v12, v60
  v_add_f32 v13, v13, v61
  v_add_f32 v14, v14, v62
  v_add_f32 v15, v15, v63
  v_add_u32 v12, 0x80, v12
  v_add_u32 v13, 0x80, v13
  v_add_u32 v14, 0x80, v14
  v_add_u32 v15, 0x80, v15
  v_and_or_b32 v12, v12, v7, s41
  v_and_or_b32 v13, v13, v7, s49
  v_and_or_b32 v14, v14, v7, s50
  v_and_or_b32 v15, v15, v7, s51
  buffer_store_dwordx4 v[12:15], v36, s[28:31], s40 offen
  s_waitcnt vmcnt(0)
L_wf6:
  ds_read_b32 v33, v24 offset:12
  s_sub_u32 s58, s58, 1
  s_cbranch_scc1 L_end
  s_sleep 1
  s_waitcnt lgkmcnt(0)
  v_cmp_gt_u32 vcc, 4, v33
  s_cbranch_vccnz L_wf6
  s_branch L_pollh1
L_retry1:
  s_cmp_lg_u32 s59, 131069
  s_cbranch_scc1 L_pollh1
  buffer_store_dwordx4 v[12:15], v36, s[28:31], s40 offen sc1
L_pollh1:
  buffer_load_dwordx4 v[56:59], v1, s[28:31], s54 offen offset:0 sc1 nt
  buffer_load_dwordx4 v[60:63], v1, s[28:31], s54 offen offset:1024 sc1 nt
  buffer_load_dwordx4 v[64:67], v1, s[28:31], s54 offen offset:2048 sc1 nt
  buffer_load_dwordx4 v[68:71], v1, s[28:31], s54 offen offset:3072 sc1 nt
  buffer_load_dwordx4 v[72:75], v1, s[28:31], s55 offen offset:0 sc1 nt
  buffer_load_dwordx4 v[76:79], v1, s[28:31], s55 offen offset:1024 sc1 nt
  buffer_load_dwordx4 v[80:83], v1, s[28:31], s55 offen offset:2048 sc1 nt
  buffer_load_dwordx4 v[84:87], v1, s[28:31], s55 offen offset:3072 sc1 nt
  buffer_load_dwordx4 v[88:91], v37, s[28:31], s43 offen sc1 nt
  v_mov_b32 v33, 0
  v_mov_b32 v35, 0
  s_sub_u32 s59, s59, 1
  s_cbranch_scc1 L_end
  s_waitcnt vmcnt(8)
  v_xor_b32 v56, s41, v56
  v_xor_b32 v57, s49, v57
  v_xor_b32 v58, s50, v58
  v_xor_b32 v59, s51, v59
  v_or_b32 v35, v35, v56
  v_or3_b32 v33, v33, v57, v58
  v_or_b32 v33, v33, v59
  s_waitcnt vmcnt(7)
  v_xor_b32 v60, s41, v60
  v_xor_b32 v61, s49, v61
  v_xor_b32 v62, s50, v62
  v_xor_b32 v63, s51, v63
  v_or_b32 v35, v35, v60
  v_or3_b32 v33, v33, v61, v62
  v_or_b32 v33, v33, v63
  v_add_f32 v56, v56, v60
  v_add_f32 v57, v57, v61
  v_add_f32 v58, v58, v62
  v_add_f32 v59, v59, v63
  s_waitcnt vmcnt(6)
  v_xor_b32 v64, s41, v64
  v_xor_b32 v65, s49, v65
  v_xor_b32 v66, s50, v66
  v_xor_b32 v67, s51, v67
  v_or_b32 v35, v35, v64
  v_or3_b32 v33, v33, v65, v66
  v_or_b32 v33, v33, v67
  v_add_f32 v56, v56, v64
  v_add_f32 v57, v57, v65
  v_add_f32 v58, v58, v66
  v_add_f32 v59, v59, v67
  s_waitcnt vmcnt(5)
  v_xor_b32 v68, s41, v68
  v_xor_b32 v69, s49, v69
  v_xor_b32 v70, s50, v70
  v_xor_b32 v71, s51, v71
  v_or_b32 v35, v35, v68
  v_or3_b32 v33, v33, v69, v70
  v_or_b32 v33, v33, v71
  v_add_f32 v56, v56, v68
  v_add_f32 v57, v57, v69
  v_add_f32 v58, v58, v70
  v_add_f32 v59, v59, v71
  s_waitcnt vmcnt(4)
  v_xor_b32 v72, s41, v72
  v_xor_b32 v73, s49, v73
  v_xor_b32 v74, s50, v74
  v_xor_b32 v75, s51, v75
  v_or_b32 v35, v35, v72
  v_or3_b32 v33, v33, v73, v74
  v_or_b32 v33, v33, v75
  v_add_f32 v56, v56, v72
  v_add_f32 v57, v57, v73
  v_add_f32 v58, v58, v74
  v_add_f32 v59, v59, v75
  s_waitcnt vmcnt(3)
  v_xor_b32 v76, s41, v76
  v_xor_b32 v77, s49, v77
  v_xor_b32 v78, s50, v78
  v_xor_b32 v79, s51, v79
  v_or_b32 v35, v35, v76
  v_or3_b32 v33, v33, v77, v78
  v_or_b32 v33, v33, v79
  v_add_f32 v56, v56, v76
  v_add_f32 v57, v57, v77
  v_add_f32 v58, v58, v78
  v_add_f32 v59, v59, v79
  s_waitcnt vmcnt(2)
  v_xor_b32 v80, s41, v80
  v_xor_b32 v81, s49, v81
  v_xor_b32 v82, s50, v82
  v_xor_b32 v83, s51, v83
  v_or_b32 v35, v35, v80
  v_or3_b32 v33, v33, v81, v82
  v_or_b32 v33, v33, v83
  v_add_f32 v56, v56, v80
  v_add_f32 v57, v57, v81
  v_add_f32 v58, v58, v82
  v_add_f32 v59, v59, v83
  s_waitcnt vmcnt(1)
  v_xor_b32 v84, s41, v84
  v_xor_b32 v85, s49, v85
  v_xor_b32 v86, s50, v86
  v_xor_b32 v87, s51, v87
  v_or_b32 v35, v35, v84
  v_or3_b32 v33, v33, v85, v86
  v_or_b32 v33, v33, v87
  v_add_f32 v56, v56, v84
  v_add_f32 v57, v57, v85
  v_add_f32 v58, v58, v86
  v_add_f32 v59, v59, v87
  s_waitcnt vmcnt(0)
  v_xor_b32 v88, s41, v88
  v_xor_b32 v89, s49, v89
  v_xor_b32 v90, s50, v90
  v_xor_b32 v91, s51, v91
  v_or_b32 v35, v35, v88
  v_or3_b32 v33, v33, v89, v90
  v_or_b32 v33, v33, v91
  v_and_b32 v34, 0xf8, v35
  v_or_b32 v33, v33, v34
  v_cmp_ne_u32_sdwa vcc, v33, v24 src0_sel:BYTE_0 src1_sel:DWORD
  v_and_b32 v35, 7, v35
  s_cbranch_vccnz L_retry1
  v_cmp_ne_u32 vcc, 0, v35
  s_cbranch_vccz L_same
  s_mov_b32 s85, 1
  buffer_store_dwordx4 v[12:15], v36, s[28:31], s40 offen sc1
L_same:
  v_cvt_pk_bf16_f32 v56, v56, v57
  v_cvt_pk_bf16_f32 v57, v58, v59
  v_lshlrev_b32 v34, 3, v0
  v_mov_b32 v58, s85
  v_mov_b32 v59, s47
  ds_write_b64 v34, v[56:57] offset:512
  ds_write_b64 v24, v[58:59] offset:32
  s_mov_b64 exec, 1
  ds_add_u32 v24, v25 offset:0
  s_mov_b64 exec, -1
  s_mov_b32 s3, 8
  s_mov_b32 s22, 5308416
  s_mov_b32 s23, 0x20000
  s_mov_b32 s27, 0x20000
  s_cmp_eq_u32 s39, 1
  s_cselect_b32 s26, 4718592, s22
  v_lshrrev_b32 v33, 5, v0
  v_bfe_u32 v34, v0, 3, 1
  v_bfe_u32 v35, v0, 4, 1
  v_lshl_add_u32 v36, v34, 1, v35
  v_add_u32 v36, 14, v36
  v_lshl_add_u32 v33, v33, 1, v34
  v_lshl_add_u32 v33, v33, 2, v35
  v_and_b32 v34, 7, v0
  v_lshlrev_b32 v34, 4, v34
  v_and_b32 v35, 32, v0
  v_mul_u32_u24 v5, 1152, v33
  v_lshl_add_u32 v3, v5, 3, v34
  v_add_u32 v5, v5, v34
  v_mul_u32_u24 v6, 1152, v36
  v_lshl_add_u32 v34, v35, 25, v34
  v_lshl_add_u32 v4, v6, 3, v34
  v_add_u32 v6, v6, v34
  s_lshl_b32 s54, s39, 30
  v_or_b32 v6, s54, v6
  v_lshrrev_b32 v31, 3, v0
  v_lshlrev_b32 v31, 4, v31
  v_and_b32 v33, 384, v9
  v_add_u32 v31, v31, v33
  s_mul_i32 s54, s52, 36
  s_mul_i32 s56, s38, 576
  s_add_u32 s54, s54, s56
  s_lshl_b32 s56, s87, 8
  s_lshl_b32 s57, s42, 5
  s_add_u32 s56, s56, s57
  s_cmp_eq_u32 s39, 1
  s_cselect_b32 s54, s56, s54
  s_mul_i32 s46, s54, 1152
  s_lshl_b32 s55, s3, 7
  s_add_u32 s46, s46, s55
  s_mul_i32 s45, s37, 331776
  s_mul_i32 s54, s38, 1152
  s_add_u32 s45, s45, s54
  s_add_u32 s45, s45, s55
  s_mov_b32 s53, 1069066811
  s_xor_b32 s54, s39, 1
  s_lshl_b32 s54, s54, 4
  s_add_u32 s54, s54, s52
  s_mul_i32 s89, s54, 4736
  s_add_u32 s89, s89, s86
  s_lshl_b32 s55, s3, 8
  s_add_u32 s41, s89, s55
  v_bfe_u32 v33, v2, 4, 4
  s_lshl_b32 s55, s3, 4
  v_add_u32 v33, s55, v33
  v_mul_u32_u24 v34, 57, v33
  v_lshrrev_b32 v34, 9, v34
  v_mul_u32_u24 v35, 9, v34
  v_sub_u32 v33, v33, v35
  v_mul_u32_u24 v34, 4736, v34
  v_lshrrev_b32 v35, 1, v33
  v_lshl_add_u32 v34, v35, 10, v34
  v_and_b32 v33, 1, v33
  v_lshl_add_u32 v34, v33, 4, v34
  s_lshl_b32 s54, s37, 6
  s_and_b32 s55, s36, 8
  s_lshl_b32 s55, s55, 2
  s_add_u32 s54, s54, s55
  s_lshr_b32 s55, s54, 1
  v_lshrrev_b32 v35, 2, v35
  v_mul_u32_u24 v35, s55, v35
  v_sub_u32 v34, v34, v35
  v_and_b32 v33, 0x40000008, v2
  v_or_b32 v11, v33, v34
  s_add_u32 s40, s54, s86
  s_add_u32 s40, s40, 75776
  v_mov_b32 v140, 0
  v_mov_b32 v141, 0
  v_mov_b32 v142, 0
  v_mov_b32 v143, 0
  v_lshrrev_b32 v30, 1, v0
  v_and_b32 v30, 16, v30
  v_lshrrev_b32 v30, v30, s47
  v_and_b32 v29, 0xff, v30
  v_bfe_u32 v30, v30, 8, 8
  buffer_load_dwordx4 v[120:123], v3, s[20:23], s45 offen nt
  s_add_u32 s45, s45, 147456
  buffer_load_dwordx4 v[124:127], v3, s[20:23], s45 offen nt
  s_sub_u32 s45, s45, 129024
  buffer_load_dwordx4 v[128:131], v3, s[20:23], s45 offen nt
  s_add_u32 s45, s45, 147456
  buffer_load_dwordx4 v[132:135], v3, s[20:23], s45 offen nt
  buffer_load_dwordx4 v[136:139], v4, s[20:23], s45 offen nt
  ds_read_b128 v[88:91], v1 offset:11776
  ds_read_b128 v[92:95], v1 offset:12800
  ds_read_b128 v[96:99], v1 offset:13824
  v_mov_b32 v76, 0
  v_mov_b32 v77, 0
  v_mov_b32 v78, 0
  v_mov_b32 v79, 0
  s_waitcnt lgkmcnt(0)
  v_mov_b32 v12, 0
  v_mov_b32 v13, 0
  v_mov_b32 v14, 0
  v_mov_b32 v15, 0
  s_waitcnt vmcnt(4)
  s_waitcnt vmcnt(3)
  v_smfmac_f32_16x16x64_bf16 v[12:15], v[88:91], v[120:127], v10
  s_waitcnt vmcnt(2)
  s_waitcnt vmcnt(1)
  v_smfmac_f32_16x16x64_bf16 v[12:15], v[92:95], v[128:135], v10
  s_waitcnt vmcnt(0)
  v_smfmac_f32_16x16x64_bf16 v[12:15], v[96:99], v[136:143], v10
  s_cmp_lg_u32 s85, 0
  s_nop 6
  v_permlane32_swap_b32 v12, v14
  v_permlane32_swap_b32 v13, v15
  s_nop 0
  v_add_f32_dpp v12, v14, v12 row_ror:8 row_mask:0xf bank_mask:0xf
  v_add_f32_dpp v13, v15, v13 row_ror:8 row_mask:0xf bank_mask:0xf
  v_and_or_b32 v12, v12, v7, v29
  v_and_or_b32 v13, v13, v7, v30
  s_cbranch_scc1 L_ps7
  buffer_store_dwordx2 v[12:13], v11, s[28:31], s40 offen
  s_branch L_pe7
L_ps7:
  buffer_store_dwordx2 v[12:13], v11, s[28:31], s40 offen sc1
L_pe7:
  s_cmp_eq_u32 s39, 1
  s_cselect_b32 s54, 6, 4
  s_cselect_b32 s55, 2, 5
  s_cselect_b32 s91, s89, 1073741824
  s_sub_u32 s42, s3, s54
  s_lshl_b32 s54, s42, 10
  s_add_u32 s90, s89, s54
  s_cmp_lt_u32 s42, s55
  s_cselect_b32 s90, s90, 1073741824
  s_cselect_b32 s91, s91, 1073741824
  s_cselect_b32 s42, s42, 9
  s_cmp_eq_u32 s42, 4
  s_cselect_b32 s54, 1, 0
  s_cselect_b32 s57, 16, 128
  v_lshrrev_b32 v48, s54, v0
  v_lshlrev_b32 v48, 4, v48
  v_lshrrev_b32 v51, 2, v0
  v_lshlrev_b32 v51, 4, v51
  s_cselect_b32 s55, 8, s42
  s_cselect_b32 s54, 0, -1
  s_add_u32 s56, s39, 5
  s_lshl_b32 s55, s55, s56
  s_bfm_b32 s56, s56, 0
  s_and_b32 s56, s56, s54
  v_and_b32 v49, s56, v1
  v_add_u32 v49, s55, v49
  v_bfe_u32 v35, v0, 4, 1
  v_mul_u32_u24 v35, s57, v35
  v_add_u32 v49, v49, v35
  v_lshrrev_b32 v35, 5, v0
  v_lshl_add_u32 v49, v35, 3, v49
  v_and_b32 v35, 388, v9
  v_add_u32 v49, v49, v35
  s_lshl_b32 s54, s39, 1
  s_xor_b32 s54, s54, 2
  v_and_b32 v35, s54, v0
  v_cmp_eq_u32 vcc, 0, v35
  v_mov_b32 v35, 800
  s_nop 0
  v_cndmask_b32 v49, v35, v49, vcc
  v_and_b32 v36, 32, v0
  v_lshlrev_b32 v36, 1, v36
  v_lshrrev_b32 v34, 3, v0
  v_mul_u32_u24 v34, 9472, v34
  v_and_b32 v35, 7, v0
  v_lshl_add_u32 v38, v35, 27, v34
  v_and_b32 v35, 4, v0
  v_lshl_add_u32 v34, v35, 8, v34
  v_and_b32 v35, 3, v0
  v_lshl_add_u32 v34, v35, 4, v34
  s_lshr_b32 s54, s36, 3
  s_mul_i32 s54, s54, 4736
  s_add_u32 s54, s54, s86
  s_lshl_b32 s55, s37, 4
  s_add_u32 s55, s55, s54
  s_lshl_b32 s56, s37, 6
  s_add_u32 s54, s54, s56
  v_mov_b32 v46, 0
  v_mov_b32 v47, 0
L_wf8:
  ds_read_b32 v33, v24 offset:4
  s_sub_u32 s58, s58, 1
  s_cbranch_scc1 L_end
  s_sleep 1
  s_waitcnt lgkmcnt(0)
  v_cmp_gt_u32 vcc, 8, v33
  s_cbranch_vccnz L_wf8
  ds_read_b128 v[120:123], v36 offset:1024
  ds_read_b128 v[124:127], v36 offset:1040
  ds_read_b128 v[128:131], v36 offset:1056
  ds_read_b128 v[132:135], v36 offset:1072
  ds_read_b128 v[88:91], v1 offset:3584
  ds_read_b128 v[92:95], v1 offset:4608
  ds_read_b128 v[96:99], v1 offset:5632
  ds_read_b128 v[100:103], v1 offset:6656
  ds_read_b128 v[104:107], v1 offset:7680
  ds_read_b128 v[108:111], v1 offset:8704
  ds_read_b128 v[112:115], v1 offset:9728
  ds_read_b128 v[116:119], v1 offset:10752
  s_waitcnt lgkmcnt(8)
  v_max3_f32 v44, v120, v122, v124
  v_max3_f32 v35, v126, v128, v130
  v_max3_f32 v44, v44, v132, v134
  v_max_f32 v44, v44, v35
  v_mul_f32 v35, s53, v44
  v_fma_f32 v120, v120, s53, -v35
  v_fma_f32 v122, v122, s53, -v35
  v_fma_f32 v124, v124, s53, -v35
  v_fma_f32 v126, v126, s53, -v35
  v_fma_f32 v128, v128, s53, -v35
  v_fma_f32 v130, v130, s53, -v35
  v_fma_f32 v132, v132, s53, -v35
  v_fma_f32 v134, v134, s53, -v35
  v_exp_f32 v120, v120
  v_exp_f32 v122, v122
  v_exp_f32 v124, v124
  v_exp_f32 v126, v126
  v_exp_f32 v128, v128
  v_exp_f32 v130, v130
  v_exp_f32 v132, v132
  v_exp_f32 v134, v134
  v_mul_f32 v45, v120, v121
  v_fmac_f32 v45, v122, v123
  v_fmac_f32 v45, v124, v125
  v_fmac_f32 v45, v126, v127
  v_fmac_f32 v45, v128, v129
  v_fmac_f32 v45, v130, v131
  v_fmac_f32 v45, v132, v133
  v_fmac_f32 v45, v134, v135
  s_waitcnt lgkmcnt(0)
  v_mul_f32 v16, v120, v88
  v_mul_f32 v17, v120, v89
  v_mul_f32 v18, v120, v90
  v_mul_f32 v19, v120, v91
  v_fmac_f32 v16, v122, v92
  v_fmac_f32 v17, v122, v93
  v_fmac_f32 v18, v122, v94
  v_fmac_f32 v19, v122, v95
  v_fmac_f32 v16, v124, v96
  v_fmac_f32 v17, v124, v97
  v_fmac_f32 v18, v124, v98
  v_fmac_f32 v19, v124, v99
  v_fmac_f32 v16, v126, v100
  v_fmac_f32 v17, v126, v101
  v_fmac_f32 v18, v126, v102
  v_fmac_f32 v19, v126, v103
  v_fmac_f32 v16, v128, v104
  v_fmac_f32 v17, v128, v105
  v_fmac_f32 v18, v128, v106
  v_fmac_f32 v19, v128, v107
  v_fmac_f32 v16, v130, v108
  v_fmac_f32 v17, v130, v109
  v_fmac_f32 v18, v130, v110
  v_fmac_f32 v19, v130, v111
  v_fmac_f32 v16, v132, v112
  v_fmac_f32 v17, v132, v113
  v_fmac_f32 v18, v132, v114
  v_fmac_f32 v19, v132, v115
  v_fmac_f32 v16, v134, v116
  v_fmac_f32 v17, v134, v117
  v_fmac_f32 v18, v134, v118
  v_fmac_f32 v19, v134, v119
  v_and_or_b32 v16, v16, v7, s48
  v_and_or_b32 v17, v17, v7, s49
  v_and_or_b32 v18, v18, v7, s50
  v_and_or_b32 v19, v19, v7, s51
  v_and_or_b32 v44, v44, v7, s48
  v_and_or_b32 v45, v45, v7, s49
  v_and_or_b32 v46, v46, v7, s50
  v_and_or_b32 v47, v47, v7, s51
  s_cmp_lg_u32 s85, 0
  s_cbranch_scc1 L_ps9
  buffer_store_dwordx4 v[16:19], v34, s[28:31], s54 offen
  buffer_store_dwordx4 v[44:47], v38, s[28:31], s55 offen offset:2048
  s_branch L_pe9
L_ps9:
  buffer_store_dwordx4 v[16:19], v34, s[28:31], s54 offen sc1
  buffer_store_dwordx4 v[44:47], v38, s[28:31], s55 offen offset:2048 sc1
L_pe9:
L_wf10:
  ds_read_b32 v33, v24 offset:12
  s_sub_u32 s58, s58, 1
  s_cbranch_scc1 L_end
  s_sleep 1
  s_waitcnt lgkmcnt(0)
  v_cmp_gt_u32 vcc, 16, v33
  s_cbranch_vccnz L_wf10
  buffer_load_dwordx4 v[56:59], v5, s[24:27], s46 offen nt
  s_add_u32 s46, s46, 18432
  buffer_load_dwordx4 v[60:63], v5, s[24:27], s46 offen nt
  s_sub_u32 s46, s46, 16128
  s_branch L_eg
L_fin:
L_end:
  s_endpgm
.section .rodata,"a"
.p2align 6
.amdhsa_kernel parallel_sum__sliding_block_cached__geglu_ffn__decode_kernel
  .amdhsa_next_free_vgpr 144
  .amdhsa_next_free_sgpr 100
  .amdhsa_accum_offset 144
  .amdhsa_group_segment_fixed_size 0
  .amdhsa_kernarg_size 96
  .amdhsa_user_sgpr_count 2
  .amdhsa_user_sgpr_kernarg_segment_ptr 1
  .amdhsa_system_sgpr_workgroup_id_x 1
.end_amdhsa_kernel
```
